```python
import torch

def _softmax(x, axis=-1):
    return torch.softmax(x, dim=axis)
def _gelu(x):
    return torch.nn.functional.gelu(x, approximate="tanh")
def _silu(x):
    return torch.nn.functional.silu(x)
def _sigmoid(x):
    return torch.sigmoid(x)
def _layernorm(x, axis=-1, eps=1e-5):
    m = x.mean(dim=axis, keepdim=True)
    v = x.var(dim=axis, keepdim=True, unbiased=False)
    return (x - m) / torch.sqrt(v + eps)
def _scatter_add(tgt, idx, src, axis=0):
    return tgt.clone().index_add_(axis, idx, src)
def _segment_sum(src, seg, n):
    out = torch.zeros((n,) + src.shape[1:], dtype=src.dtype)
    return out.index_add_(0, seg, src)
def _pad(x, pw):
    flat = tuple(v for pair in reversed(pw) for v in pair)
    return torch.nn.functional.pad(x, flat)

kernel_name = 'gated_mix__sliding_block_cached__dense_activation_gelu__decode'

def setup_inputs():

    _w = (lambda a: (lambda t: t.to(torch.bfloat16) if t.is_floating_point() else t)(torch.as_tensor(a)))
    def _A_setup():
        B, Sq, D = 1, 1, 640
        Hq, Hkv, Sk, Dh = 32, 32, 32768, 192
        assert Hq % Hkv == 0, (Hq, Hkv)
        return {
            "x": _w((lambda *s: torch.randn(*s, dtype=torch.bfloat16) * 0.05)(B, Sq, D)),
            "k_cache": _w((lambda *s: torch.randn(*s, dtype=torch.bfloat16) * 6.4)(B, Hkv, Sk, Dh)),
            "v_cache": _w((lambda *s: torch.randn(*s, dtype=torch.bfloat16) * 0.2)(B, Hkv, Sk, Dh)),
            "wq": _w((lambda *s: torch.randn(*s, dtype=torch.bfloat16) * 6.4)(D, Hq * Dh) * (D ** -0.5)),
            "wo": _w((lambda *s: torch.randn(*s, dtype=torch.bfloat16) * 0.2)(Hq * Dh, D) * ((Hq * Dh) ** -0.5)),
        }
    _A_in = _A_setup()

    def _B_setup():
        B, S, D, F = 1, 1, 640, 1536
        return {
            "x": _w((lambda *s: torch.randn(*s, dtype=torch.bfloat16) * 0.05)(B, S, D)),
            "w1": _w((lambda *s: torch.randn(*s, dtype=torch.bfloat16) * 3.2)(D, F) * (D ** -0.5)),
            "b1": _w((lambda *s: torch.randn(*s, dtype=torch.bfloat16) * 3.2)(F) * 0.01),
            "w2": _w((lambda *s: torch.randn(*s, dtype=torch.bfloat16) * 0.05)(F, D) * (F ** -0.5)),
            "b2": _w((lambda *s: torch.randn(*s, dtype=torch.bfloat16) * 0.05)(D) * 0.01),
        }
    _B_in = _B_setup()

    return {
        "A_x": _A_in["x"],
        "A_k_cache": _A_in["k_cache"],
        "A_v_cache": _A_in["v_cache"],
        "A_wq": _A_in["wq"],
        "A_wo": _A_in["wo"],
        "B_x": _B_in["x"],
        "B_w1": _B_in["w1"],
        "B_b1": _B_in["b1"],
        "B_w2": _B_in["w2"],
        "B_b2": _B_in["b2"],
        "gate_w": _w((lambda *s: torch.randn(*s, dtype=torch.bfloat16) * 0.05)(640) * 16.0),
    }

def reference(A_x, A_k_cache, A_v_cache, A_wq, A_wo, B_x, B_w1, B_b1, B_w2, B_b2, gate_w):
    def _A_ref(x, k_cache, v_cache, wq, wo):
        B, Sq, D = x.shape
        Hq, Dh = 32, 192
        Hkv, Sk = k_cache.shape[1], k_cache.shape[2]
        W = min(4096, max(256, Sk // 4))
        rep = Hq // Hkv
        q = (lambda x, *d: x.permute(*d))((x @ wq).reshape(B, Sq, Hq, Dh), 0, 2, 1, 3)
        k = (lambda x, n, axis: torch.repeat_interleave(x, n, dim=axis))(k_cache[:, :, Sk - W:, :], rep, axis=1)
        v = (lambda x, n, axis: torch.repeat_interleave(x, n, dim=axis))(v_cache[:, :, Sk - W:, :], rep, axis=1)
        scores = torch.einsum("bhqd,bhkd->bhqk", q, k) * (Dh ** -0.5)
        p = _softmax(scores, axis=-1)
        o = torch.einsum("bhqk,bhkd->bhqd", p, v)
        return (lambda x, *d: x.permute(*d))(o, 0, 2, 1, 3).reshape(B, Sq, Hq * Dh) @ wo

    def _B_ref(x, w1, b1, w2, b2):
        h = torch.einsum("bsd,df->bsf", x, w1) + b1
        h = _gelu(h)
        return torch.einsum("bsf,fd->bsd", h, w2) + b2

    x = A_x
    g = _sigmoid((x * gate_w).sum(-1, keepdims=True))
    a = _A_ref(x, A_k_cache, A_v_cache, A_wq, A_wo)
    b = _B_ref(x, B_w1, B_b1, B_w2, B_b2)
    return g * a + (1 - g) * b
```

```asm
; @launch grid=(256,1,1) block=(768,1,1) lds=31808
.amdgcn_target "amdgcn-amd-amdhsa--gfx950"
.text
.globl gated_mix__sliding_block_cached__dense_activation_gelu__decode_kernel
.p2align 8
.type gated_mix__sliding_block_cached__dense_activation_gelu__decode_kernel,@function
gated_mix__sliding_block_cached__dense_activation_gelu__decode_kernel:
    s_load_dwordx2 s[4:5], s[0:1], 8
    s_cmpk_ge_u32 s2, 0x100
    s_cbranch_scc1 L_end
    v_lshrrev_b32 v2, 6, v0
    v_and_b32 v1, 63, v0
    v_readfirstlane_b32 s67, v2
    s_lshr_b32 s65, s2, 5
    v_lshrrev_b32 v2, 3, v1
    v_and_b32 v3, 7, v1
    s_cmp_ge_u32 s67, 8
    s_cbranch_scc1 L_ctl
    s_and_b32 s69, s2, 15
    s_lshl_b32 s69, s69, 10
    s_and_b32 s68, s2, 16
    s_add_u32 s69, s69, s68
    s_lshl_b32 s68, s67, 3
    s_lshl2_add_u32 s68, s69, s68
    s_add_u32 s68, s68, s65
    s_addk_i32 s68, 3584
    s_mulk_i32 s68, 3072
    v_mul_u32_u24 v4, 24, v2
    v_add_u32 v4, v4, v3
    v_lshl_add_u32 v4, v4, 4, s68
    s_mov_b32 s6, 402653184
    s_mov_b32 s7, 0x20000
    s_waitcnt lgkmcnt(0)
    buffer_load_dwordx4 v[64:67], v4, s[4:7], 0 offen offset:0 nt
    buffer_load_dwordx4 v[68:71], v4, s[4:7], 0 offen offset:128 nt
    buffer_load_dwordx4 v[72:75], v4, s[4:7], 0 offen offset:256 nt
    s_mov_b32 s71, 393216
    buffer_load_dwordx4 v[76:79], v4, s[4:7], s71 offen offset:0 nt
    s_load_dwordx16 s[36:51], s[0:1], 0
    s_load_dwordx8 s[52:59], s[0:1], 64
    s_load_dwordx4 s[60:63], s[0:1], 96
    s_add_u32 s3, s67, 4
    s_mov_b32 s10, 402653184
    s_mov_b32 s11, 0x20000
    s_barrier
    s_waitcnt vmcnt(2)
    buffer_load_dwordx4 v[80:83], v4, s[4:7], s71 offen offset:128 nt
    s_waitcnt vmcnt(2)
    buffer_load_dwordx4 v[84:87], v4, s[4:7], s71 offen offset:256 nt
    s_mov_b32 s71, 786432
    s_waitcnt vmcnt(2)
    buffer_load_dwordx4 v[88:91], v4, s[4:7], s71 offen offset:0 nt
    s_waitcnt vmcnt(2)
    buffer_load_dwordx4 v[92:95], v4, s[4:7], s71 offen offset:128 nt
    s_waitcnt vmcnt(2)
    buffer_load_dwordx4 v[96:99], v4, s[4:7], s71 offen offset:256 nt
    s_mov_b32 s71, 1179648
    s_waitcnt vmcnt(2)
    buffer_load_dwordx4 v[100:103], v4, s[4:7], s71 offen offset:0 nt
    s_waitcnt vmcnt(2)
    buffer_load_dwordx4 v[104:107], v4, s[4:7], s71 offen offset:128 nt
    s_waitcnt lgkmcnt(0)
    s_mov_b32 s8, s40
    s_and_b32 s9, s41, 0xffff
    s_and_b32 s28, s2, 7
    s_lshr_b32 s29, s2, 3
    s_mul_i32 s101, s29, 52
    s_lshr_b32 s101, s101, 8
    s_min_u32 s101, s101, 5
    s_lshl_b32 s64, s28, 2
    s_and_b32 s68, s29, 1
    s_add_u32 s64, s64, s68
    s_mov_b32 s20, s62
    s_and_b32 s21, s63, 0xffff
    s_mov_b32 s22, 1048576
    s_mov_b32 s23, 0x20000
    s_mov_b32 s30, 0x0c0c0400
    s_mov_b32 s31, 0x04000c0c
    v_and_b32 v5, 1, v1
    v_lshlrev_b32 v5, 4, v5
    v_mov_b32 v6, 0xffff
    v_lshlrev_b32 v6, v5, v6
    v_lshrrev_b32 v5, 1, v3
    v_cmp_eq_u32 vcc, 0, v5
    s_nop 1
    v_cndmask_b32 v16, 0, v6, vcc
    v_cmp_eq_u32 vcc, 1, v5
    s_nop 1
    v_cndmask_b32 v17, 0, v6, vcc
    v_cmp_eq_u32 vcc, 2, v5
    s_nop 1
    v_cndmask_b32 v18, 0, v6, vcc
    v_cmp_eq_u32 vcc, 3, v5
    s_nop 1
    v_cndmask_b32 v19, 0, v6, vcc
    v_mov_b32 v15, 0xff
    v_and_b32 v6, 16, v1
    v_lshl_add_u32 v6, v3, 5, v6
    v_lshrrev_b32 v7, 5, v1
    v_mul_u32_u24 v5, 768, v7
    v_add_u32 v5, v5, v6
    s_mul_i32 s68, s67, 1568
    v_add_u32 v5, s68, v5
    v_and_b32 v12, 15, v1
    v_and_b32 v6, 16, v1
    v_lshl_add_u32 v12, v12, 5, v6
    s_mul_i32 s68, s67, 640
    v_add_u32 v12, s68, v12
    v_lshrrev_b32 v7, 4, v1
    v_sub_u32 v7, v3, v7
    v_and_b32 v7, 7, v7
    v_mul_u32_u24 v6, 1568, v7
    v_lshl_add_u32 v6, v2, 4, v6
    s_mul_i32 s68, s67, 96
    v_add_u32 v6, s68, v6
    v_mul_u32_u24 v36, 640, v2
    v_lshl_add_u32 v36, v3, 4, v36
    s_and_b32 s68, s67, 3
    s_lshl_b32 s68, s68, 7
    v_add_u32 v36, s68, v36
    v_lshlrev_b32 v7, 2, v7
    s_lshl_b32 s68, s67, 4
    v_mov_b32 v8, s68
    v_mov_b32 v9, 0
    s_lshl_b32 s68, s64, 3
    s_add_u32 s68, s68, s67
    s_mul_i32 s68, s68, 768
    s_and_b32 s69, s2, 0x70
    s_add_u32 s68, s68, s69
    s_cmp_lt_u32 s2, 128
    s_cselect_b32 s69, 0, 258048
    s_add_u32 s68, s68, s69
    s_add_u32 s68, s68, 4096
    v_lshl_add_u32 v10, v2, 7, s68
    s_movk_i32 s34, 12288
    v_lshlrev_b32 v11, 4, v3
    s_mov_b32 s32, 0x00ff00ff
    s_mov_b32 s33, 0x00ff00ff
    s_mov_b32 s46, 0x00ff00ff
    s_mov_b32 s47, 0xff00ff00
    s_mov_b32 s48, 0x01010101
    s_mov_b32 s49, 0x00000101
    s_waitcnt vmcnt(2)
    buffer_load_dwordx4 v[108:111], v4, s[4:7], s71 offen offset:256 nt
    s_mov_b32 s71, 201326592
    s_waitcnt vmcnt(2)
    buffer_load_dwordx4 v[112:115], v4, s[4:7], s71 offen offset:0 nt
    s_lshl_b32 s68, s101, 3
    s_add_u32 s68, s68, s67
    s_mul_i32 s35, s68, 43
    s_lshr_b32 s35, s35, 9
    s_mul_i32 s25, s35, 12
    s_sub_u32 s25, s68, s25
    s_lshl_b32 s69, s35, 3
    s_add_u32 s69, s69, s28
    s_mul_i32 s26, s101, 5
    s_sub_u32 s26, s29, s26
    s_lshl_b32 s24, s26, 8
    s_mul_i32 s27, s69, 12
    s_add_u32 s27, s27, s25
    s_mul_i32 s27, s27, 20480
    s_add_u32 s27, s27, s24
    s_add_u32 s12, s44, s27
    s_addc_u32 s13, s45, 0
    s_and_b32 s13, s13, 0xffff
    s_cmp_lt_u32 s29, 30
    s_cselect_b32 s14, 19456, 0
    s_cselect_b32 s18, 4096, 0
    s_cselect_b32 s26, s24, 0
    s_mov_b32 s15, 0x20000
    s_mov_b32 s19, 0x20000
    s_mul_i32 s27, s28, 48
    s_add_u32 s27, s27, s68
    s_mul_i32 s27, s27, 5120
    s_add_u32 s27, s27, s24
    s_add_u32 s16, s52, s27
    s_addc_u32 s17, s53, 0
    s_and_b32 s17, s17, 0xffff
    s_mul_i32 s69, s28, 24576
    s_lshl_b32 s25, s68, 9
    s_add_u32 s69, s69, s25
    s_add_u32 s69, s69, 4096
    v_lshrrev_b32 v164, 4, v1
    v_and_b32 v165, 15, v1
    v_mul_u32_u24 v38, 1280, v164
    v_lshlrev_b32 v13, 4, v165
    v_lshl_add_u32 v37, v38, 2, v13
    v_add_u32 v38, v38, v13
    v_lshl_add_u32 v14, v164, 7, s69
    v_add_u32 v14, v14, v11
    v_and_b32 v13, 8, v1
    v_mul_u32_u24 v13, 32256, v13
    v_add_u32 v14, v14, v13
    s_lshl_b32 s68, s67, 4
    v_lshl_add_u32 v39, v164, 2, s68
    s_lshr_b32 s25, s26, 6
    s_and_b32 s26, s67, 3
    s_add_u32 s25, s25, s26
    s_lshl_b32 s26, s25, 9
    s_add_u32 s26, s26, 589824
    v_lshl_add_u32 v13, v164, 7, s26
    v_lshl_add_u32 v13, v165, 2, v13
    v_and_b32 v165, 1, v164
    v_lshrrev_b32 v164, 1, v164
    v_lshl_add_u32 v164, v165, 1, v164
    v_lshl_add_u32 v164, v3, 2, v164
    s_lshl_b32 s26, s25, 6
    v_lshl_add_u32 v164, v164, 1, s26
    global_load_ushort v40, v164, s[54:55]
    s_waitcnt vmcnt(2)
    buffer_load_dwordx4 v[116:119], v4, s[4:7], s71 offen offset:128 nt
    s_waitcnt vmcnt(2)
    buffer_load_dwordx4 v[120:123], v4, s[4:7], s71 offen offset:256 nt
    s_mov_b32 s71, 201719808
    s_waitcnt vmcnt(2)
    buffer_load_dwordx4 v[124:127], v4, s[4:7], s71 offen offset:0 nt
    s_waitcnt vmcnt(2)
    buffer_load_dwordx4 v[128:131], v4, s[4:7], s71 offen offset:128 nt
    s_waitcnt vmcnt(2)
    buffer_load_dwordx4 v[132:135], v4, s[4:7], s71 offen offset:256 nt
    s_mov_b32 s71, 202113024
    s_waitcnt vmcnt(2)
    buffer_load_dwordx4 v[136:139], v4, s[4:7], s71 offen offset:0 nt
    s_waitcnt vmcnt(2)
    buffer_load_dwordx4 v[140:143], v4, s[4:7], s71 offen offset:128 nt
    s_waitcnt vmcnt(2)
    buffer_load_dwordx4 v[144:147], v4, s[4:7], s71 offen offset:256 nt
    s_mov_b32 s71, 202506240
    s_waitcnt vmcnt(2)
    buffer_load_dwordx4 v[148:151], v4, s[4:7], s71 offen offset:0 nt
    s_mov_b32 s68, 0
L_qw:
    ds_read_b96 v[52:54], v9 offset:768
    ds_read_b128 v[20:23], v11 offset:0
    ds_read_b128 v[24:27], v11 offset:128
    ds_read_b128 v[28:31], v11 offset:256
    s_waitcnt lgkmcnt(0)
    v_min3_f32 v52, v52, v53, v54
    v_cmp_gt_f32 vcc, 0, v52
    s_cbranch_vccz L_qr
    s_sleep 1
    s_add_u32 s68, s68, 1
    s_cmp_gt_u32 s68, 200000
    s_cbranch_scc0 L_qw
L_qr:
    v_mov_b32 v44, 0
    v_mov_b32 v45, 0
    v_dot2c_f32_bf16 v44, v64, v20
    v_dot2c_f32_bf16 v45, v76, v20
    v_dot2c_f32_bf16 v44, v65, v21
    v_dot2c_f32_bf16 v45, v77, v21
    v_dot2c_f32_bf16 v44, v66, v22
    v_dot2c_f32_bf16 v45, v78, v22
    v_dot2c_f32_bf16 v44, v67, v23
    v_dot2c_f32_bf16 v45, v79, v23
    v_dot2c_f32_bf16 v44, v68, v24
    v_dot2c_f32_bf16 v45, v80, v24
    v_dot2c_f32_bf16 v44, v69, v25
    v_dot2c_f32_bf16 v45, v81, v25
    v_dot2c_f32_bf16 v44, v70, v26
    v_dot2c_f32_bf16 v45, v82, v26
    v_dot2c_f32_bf16 v44, v71, v27
    v_dot2c_f32_bf16 v45, v83, v27
    v_dot2c_f32_bf16 v44, v72, v28
    v_dot2c_f32_bf16 v45, v84, v28
    v_dot2c_f32_bf16 v44, v73, v29
    v_dot2c_f32_bf16 v45, v85, v29
    v_dot2c_f32_bf16 v44, v74, v30
    v_dot2c_f32_bf16 v45, v86, v30
    v_dot2c_f32_bf16 v44, v75, v31
    v_dot2c_f32_bf16 v45, v87, v31
    s_nop 1
    v_add_f32_dpp v44, v44, v44 quad_perm:[1,0,3,2] row_mask:0xf bank_mask:0xf
    v_add_f32_dpp v45, v45, v45 quad_perm:[1,0,3,2] row_mask:0xf bank_mask:0xf
    s_nop 0
    v_add_f32_dpp v44, v44, v44 quad_perm:[2,3,0,1] row_mask:0xf bank_mask:0xf
    v_add_f32_dpp v45, v45, v45 quad_perm:[2,3,0,1] row_mask:0xf bank_mask:0xf
    s_nop 0
    v_add_f32_dpp v44, v44, v44 row_half_mirror row_mask:0xf bank_mask:0xf
    v_add_f32_dpp v45, v45, v45 row_half_mirror row_mask:0xf bank_mask:0xf
    v_cvt_pk_bf16_f32 v52, v44, v45
    v_lshlrev_b32 v44, 16, v52
    v_and_b32 v45, 0xffff0000, v52
    v_mul_f32 v44, 0x3d93cd3a, v44
    v_mul_f32 v45, 0x3d93cd3a, v45
    v_cvt_pk_bf16_f32 v52, v44, v45
    v_lshlrev_b32 v44, 16, v52
    v_and_b32 v45, 0xffff0000, v52
    s_waitcnt vmcnt(2)
    buffer_load_dwordx4 v[152:155], v4, s[4:7], s71 offen offset:128 nt
    v_mov_b32 v46, 0
    v_mov_b32 v47, 0
    v_dot2c_f32_bf16 v46, v88, v20
    v_dot2c_f32_bf16 v47, v100, v20
    v_dot2c_f32_bf16 v46, v89, v21
    v_dot2c_f32_bf16 v47, v101, v21
    v_dot2c_f32_bf16 v46, v90, v22
    v_dot2c_f32_bf16 v47, v102, v22
    v_dot2c_f32_bf16 v46, v91, v23
    v_dot2c_f32_bf16 v47, v103, v23
    v_dot2c_f32_bf16 v46, v92, v24
    v_dot2c_f32_bf16 v47, v104, v24
    v_dot2c_f32_bf16 v46, v93, v25
    v_dot2c_f32_bf16 v47, v105, v25
    v_dot2c_f32_bf16 v46, v94, v26
    v_dot2c_f32_bf16 v47, v106, v26
    v_dot2c_f32_bf16 v46, v95, v27
    v_dot2c_f32_bf16 v47, v107, v27
    v_dot2c_f32_bf16 v46, v96, v28
    v_dot2c_f32_bf16 v47, v108, v28
    v_dot2c_f32_bf16 v46, v97, v29
    v_dot2c_f32_bf16 v47, v109, v29
    v_dot2c_f32_bf16 v46, v98, v30
    v_dot2c_f32_bf16 v47, v110, v30
    v_dot2c_f32_bf16 v46, v99, v31
    v_dot2c_f32_bf16 v47, v111, v31
    ds_read_b128 v[20:23], v11 offset:384
    ds_read_b128 v[24:27], v11 offset:512
    ds_read_b128 v[28:31], v11 offset:640
    v_add_f32_dpp v46, v46, v46 quad_perm:[1,0,3,2] row_mask:0xf bank_mask:0xf
    v_add_f32_dpp v47, v47, v47 quad_perm:[1,0,3,2] row_mask:0xf bank_mask:0xf
    s_nop 0
    v_add_f32_dpp v46, v46, v46 quad_perm:[2,3,0,1] row_mask:0xf bank_mask:0xf
    v_add_f32_dpp v47, v47, v47 quad_perm:[2,3,0,1] row_mask:0xf bank_mask:0xf
    s_nop 0
    v_add_f32_dpp v46, v46, v46 row_half_mirror row_mask:0xf bank_mask:0xf
    v_add_f32_dpp v47, v47, v47 row_half_mirror row_mask:0xf bank_mask:0xf
    v_cvt_pk_bf16_f32 v52, v46, v47
    v_lshlrev_b32 v46, 16, v52
    v_and_b32 v47, 0xffff0000, v52
    v_mul_f32 v46, 0x3d93cd3a, v46
    v_mul_f32 v47, 0x3d93cd3a, v47
    v_cvt_pk_bf16_f32 v52, v46, v47
    v_lshlrev_b32 v46, 16, v52
    v_and_b32 v47, 0xffff0000, v52
    s_waitcnt vmcnt(2)
    buffer_load_dwordx4 v[156:159], v4, s[4:7], s71 offen offset:256 nt
    v_mov_b32 v48, 0
    v_mov_b32 v49, 0
    s_waitcnt lgkmcnt(0)
    v_dot2c_f32_bf16 v48, v112, v20
    v_dot2c_f32_bf16 v49, v124, v20
    v_dot2c_f32_bf16 v48, v113, v21
    v_dot2c_f32_bf16 v49, v125, v21
    v_dot2c_f32_bf16 v48, v114, v22
    v_dot2c_f32_bf16 v49, v126, v22
    v_dot2c_f32_bf16 v48, v115, v23
    v_dot2c_f32_bf16 v49, v127, v23
    v_dot2c_f32_bf16 v48, v116, v24
    v_dot2c_f32_bf16 v49, v128, v24
    v_dot2c_f32_bf16 v48, v117, v25
    v_dot2c_f32_bf16 v49, v129, v25
    v_dot2c_f32_bf16 v48, v118, v26
    v_dot2c_f32_bf16 v49, v130, v26
    v_dot2c_f32_bf16 v48, v119, v27
    v_dot2c_f32_bf16 v49, v131, v27
    v_dot2c_f32_bf16 v48, v120, v28
    v_dot2c_f32_bf16 v49, v132, v28
    v_dot2c_f32_bf16 v48, v121, v29
    v_dot2c_f32_bf16 v49, v133, v29
    v_dot2c_f32_bf16 v48, v122, v30
    v_dot2c_f32_bf16 v49, v134, v30
    v_dot2c_f32_bf16 v48, v123, v31
    v_dot2c_f32_bf16 v49, v135, v31
    s_nop 1
    v_add_f32_dpp v48, v48, v48 quad_perm:[1,0,3,2] row_mask:0xf bank_mask:0xf
    v_add_f32_dpp v49, v49, v49 quad_perm:[1,0,3,2] row_mask:0xf bank_mask:0xf
    s_nop 0
    v_add_f32_dpp v48, v48, v48 quad_perm:[2,3,0,1] row_mask:0xf bank_mask:0xf
    v_add_f32_dpp v49, v49, v49 quad_perm:[2,3,0,1] row_mask:0xf bank_mask:0xf
    s_nop 0
    v_add_f32_dpp v48, v48, v48 row_half_mirror row_mask:0xf bank_mask:0xf
    v_add_f32_dpp v49, v49, v49 row_half_mirror row_mask:0xf bank_mask:0xf
    v_cvt_pk_bf16_f32 v52, v48, v49
    v_lshlrev_b32 v48, 16, v52
    v_and_b32 v49, 0xffff0000, v52
    v_mul_f32 v48, 0x3d93cd3a, v48
    v_mul_f32 v49, 0x3d93cd3a, v49
    v_cvt_pk_bf16_f32 v52, v48, v49
    v_lshlrev_b32 v48, 16, v52
    v_and_b32 v49, 0xffff0000, v52
    s_mov_b32 s71, 0
    s_waitcnt vmcnt(2)
    buffer_load_dwordx4 v[64:67], v4, s[8:11], s71 offen offset:0 nt
    s_waitcnt vmcnt(2)
    buffer_load_dwordx4 v[68:71], v4, s[8:11], s71 offen offset:128 nt
    s_waitcnt vmcnt(2)
    buffer_load_dwordx4 v[72:75], v4, s[8:11], s71 offen offset:256 nt
    v_mov_b32 v50, 0
    v_mov_b32 v51, 0
    v_dot2c_f32_bf16 v50, v136, v20
    v_dot2c_f32_bf16 v51, v148, v20
    v_dot2c_f32_bf16 v50, v137, v21
    v_dot2c_f32_bf16 v51, v149, v21
    v_dot2c_f32_bf16 v50, v138, v22
    v_dot2c_f32_bf16 v51, v150, v22
    v_dot2c_f32_bf16 v50, v139, v23
    v_dot2c_f32_bf16 v51, v151, v23
    v_dot2c_f32_bf16 v50, v140, v24
    v_dot2c_f32_bf16 v51, v152, v24
    v_dot2c_f32_bf16 v50, v141, v25
    v_dot2c_f32_bf16 v51, v153, v25
    v_dot2c_f32_bf16 v50, v142, v26
    v_dot2c_f32_bf16 v51, v154, v26
    v_dot2c_f32_bf16 v50, v143, v27
    v_dot2c_f32_bf16 v51, v155, v27
    v_dot2c_f32_bf16 v50, v144, v28
    v_dot2c_f32_bf16 v51, v156, v28
    v_dot2c_f32_bf16 v50, v145, v29
    v_dot2c_f32_bf16 v51, v157, v29
    v_dot2c_f32_bf16 v50, v146, v30
    v_dot2c_f32_bf16 v51, v158, v30
    v_dot2c_f32_bf16 v50, v147, v31
    v_dot2c_f32_bf16 v51, v159, v31
    s_nop 1
    v_add_f32_dpp v50, v50, v50 quad_perm:[1,0,3,2] row_mask:0xf bank_mask:0xf
    v_add_f32_dpp v51, v51, v51 quad_perm:[1,0,3,2] row_mask:0xf bank_mask:0xf
    s_nop 0
    v_add_f32_dpp v50, v50, v50 quad_perm:[2,3,0,1] row_mask:0xf bank_mask:0xf
    v_add_f32_dpp v51, v51, v51 quad_perm:[2,3,0,1] row_mask:0xf bank_mask:0xf
    s_nop 0
    v_add_f32_dpp v50, v50, v50 row_half_mirror row_mask:0xf bank_mask:0xf
    v_add_f32_dpp v51, v51, v51 row_half_mirror row_mask:0xf bank_mask:0xf
    v_cvt_pk_bf16_f32 v52, v50, v51
    v_lshlrev_b32 v50, 16, v52
    v_and_b32 v51, 0xffff0000, v52
    v_mul_f32 v50, 0x3d93cd3a, v50
    v_mul_f32 v51, 0x3d93cd3a, v51
    v_cvt_pk_bf16_f32 v52, v50, v51
    v_lshlrev_b32 v50, 16, v52
    v_and_b32 v51, 0xffff0000, v52
    s_mov_b32 s71, 393216
    s_waitcnt vmcnt(2)
    buffer_load_dwordx4 v[76:79], v4, s[8:11], s71 offen offset:0 nt
    v_max3_f32 v52, v44, v45, v46
    v_max3_f32 v54, v48, v49, v50
    v_max_f32 v52, v52, v47
    v_max_f32 v54, v54, v51
    s_nop 0
    v_max_f32_dpp v52, v52, v52 row_ror:8 row_mask:0xf bank_mask:0xf
    v_max_f32_dpp v54, v54, v54 row_ror:8 row_mask:0xf bank_mask:0xf
    v_mov_b32 v56, v52
    v_mov_b32 v57, v54
    s_nop 0
    v_permlane16_swap_b32 v52, v56
    v_permlane16_swap_b32 v54, v57
    v_max_f32 v52, v52, v56
    v_max_f32 v54, v54, v57
    v_mov_b32 v56, v52
    v_mov_b32 v57, v54
    s_nop 0
    v_permlane32_swap_b32 v52, v56
    v_permlane32_swap_b32 v54, v57
    v_max_f32 v52, v52, v56
    v_max_f32 v54, v54, v57
    s_mov_b32 s68, 0x3fb8aa3b
    v_mul_f32 v52, s68, v52
    v_mul_f32 v54, s68, v54
    v_fma_f32 v44, v44, s68, -v52
    v_fma_f32 v45, v45, s68, -v52
    v_fma_f32 v46, v46, s68, -v52
    v_fma_f32 v47, v47, s68, -v52
    v_fma_f32 v48, v48, s68, -v54
    v_fma_f32 v49, v49, s68, -v54
    v_fma_f32 v50, v50, s68, -v54
    v_fma_f32 v51, v51, s68, -v54
    v_exp_f32 v44, v44
    v_exp_f32 v45, v45
    v_exp_f32 v46, v46
    v_exp_f32 v47, v47
    v_exp_f32 v48, v48
    v_exp_f32 v49, v49
    v_exp_f32 v50, v50
    v_exp_f32 v51, v51
    v_add_f32 v53, v44, v45
    v_add_f32 v56, v46, v47
    v_add_f32 v55, v48, v49
    v_add_f32 v57, v50, v51
    v_add_f32 v53, v53, v56
    v_add_f32 v55, v55, v57
    s_nop 0
    v_add_f32_dpp v53, v53, v53 row_ror:8 row_mask:0xf bank_mask:0xf
    v_add_f32_dpp v55, v55, v55 row_ror:8 row_mask:0xf bank_mask:0xf
    v_mov_b32 v56, v53
    v_mov_b32 v57, v55
    s_nop 0
    v_permlane16_swap_b32 v53, v56
    v_permlane16_swap_b32 v55, v57
    v_add_f32 v53, v53, v56
    v_add_f32 v55, v55, v57
    v_mov_b32 v56, v53
    v_mov_b32 v57, v55
    s_nop 0
    v_permlane32_swap_b32 v53, v56
    v_permlane32_swap_b32 v55, v57
    v_add_f32 v53, v53, v56
    v_add_f32 v55, v55, v57
    ds_write_b128 v8, v[52:55] offset:832
    v_cvt_pk_bf16_f32 v44, v44, v44
    v_and_b32 v32, v44, v16
    v_and_b32 v33, v44, v17
    v_and_b32 v34, v44, v18
    v_and_b32 v35, v44, v19
    s_waitcnt vmcnt(2)
    buffer_load_dwordx4 v[80:83], v4, s[8:11], s71 offen offset:128 nt
    s_waitcnt vmcnt(2)
    buffer_load_dwordx4 v[84:87], v4, s[8:11], s71 offen offset:256 nt
    v_mfma_f32_16x16x32_bf16 v[20:23], v[32:35], v[64:67], 0
    v_mfma_f32_16x16x32_bf16 v[24:27], v[32:35], v[68:71], 0
    v_mfma_f32_16x16x32_bf16 v[28:31], v[32:35], v[72:75], 0
    v_cvt_pk_bf16_f32 v45, v45, v45
    v_and_b32 v32, v45, v16
    v_and_b32 v33, v45, v17
    v_and_b32 v34, v45, v18
    v_and_b32 v35, v45, v19
    s_mov_b32 s71, 786432
    s_waitcnt vmcnt(2)
    buffer_load_dwordx4 v[88:91], v4, s[8:11], s71 offen offset:0 nt
    s_waitcnt vmcnt(2)
    buffer_load_dwordx4 v[92:95], v4, s[8:11], s71 offen offset:128 nt
    s_waitcnt vmcnt(2)
    buffer_load_dwordx4 v[96:99], v4, s[8:11], s71 offen offset:256 nt
    v_mfma_f32_16x16x32_bf16 v[20:23], v[32:35], v[76:79], v[20:23]
    v_mfma_f32_16x16x32_bf16 v[24:27], v[32:35], v[80:83], v[24:27]
    v_mfma_f32_16x16x32_bf16 v[28:31], v[32:35], v[84:87], v[28:31]
    v_cvt_pk_bf16_f32 v46, v46, v46
    v_and_b32 v32, v46, v16
    v_and_b32 v33, v46, v17
    v_and_b32 v34, v46, v18
    v_and_b32 v35, v46, v19
    s_mov_b32 s71, 1179648
    s_waitcnt vmcnt(2)
    buffer_load_dwordx4 v[100:103], v4, s[8:11], s71 offen offset:0 nt
    s_waitcnt vmcnt(2)
    buffer_load_dwordx4 v[104:107], v4, s[8:11], s71 offen offset:128 nt
    s_waitcnt vmcnt(2)
    buffer_load_dwordx4 v[108:111], v4, s[8:11], s71 offen offset:256 nt
    v_mfma_f32_16x16x32_bf16 v[20:23], v[32:35], v[88:91], v[20:23]
    v_mfma_f32_16x16x32_bf16 v[24:27], v[32:35], v[92:95], v[24:27]
    v_mfma_f32_16x16x32_bf16 v[28:31], v[32:35], v[96:99], v[28:31]
    v_cvt_pk_bf16_f32 v47, v47, v47
    v_and_b32 v32, v47, v16
    v_and_b32 v33, v47, v17
    v_and_b32 v34, v47, v18
    v_and_b32 v35, v47, v19
    s_mov_b32 s71, 201326592
    s_waitcnt vmcnt(2)
    buffer_load_dwordx4 v[112:115], v4, s[8:11], s71 offen offset:0 nt
    s_waitcnt vmcnt(2)
    buffer_load_dwordx4 v[116:119], v4, s[8:11], s71 offen offset:128 nt
    s_waitcnt vmcnt(2)
    buffer_load_dwordx4 v[120:123], v4, s[8:11], s71 offen offset:256 nt
    v_mfma_f32_16x16x32_bf16 v[20:23], v[32:35], v[100:103], v[20:23]
    v_mfma_f32_16x16x32_bf16 v[24:27], v[32:35], v[104:107], v[24:27]
    v_mfma_f32_16x16x32_bf16 v[28:31], v[32:35], v[108:111], v[28:31]
    v_cvt_pk_bf16_f32 v48, v48, v48
    v_and_b32 v32, v48, v16
    v_and_b32 v33, v48, v17
    v_and_b32 v34, v48, v18
    v_and_b32 v35, v48, v19
    s_mov_b64 exec, s[46:47]
    ds_write_b128 v5, v[20:23] offset:1536
    ds_write_b128 v5, v[24:27] offset:1792
    ds_write_b128 v5, v[28:31] offset:2048
    s_mov_b64 exec, -1
    s_mov_b32 s71, 201719808
    s_waitcnt vmcnt(2)
    buffer_load_dwordx4 v[124:127], v4, s[8:11], s71 offen offset:0 nt
    s_waitcnt vmcnt(2)
    buffer_load_dwordx4 v[128:131], v4, s[8:11], s71 offen offset:128 nt
    s_mov_b32 s68, 0
L_smw:
    ds_read_b128 v[52:55], v9 offset:784
    ds_read_b32 v56, v9 offset:780
    ds_read_b32 v43, v9 offset:1092
    ds_read_b32 v41, v39 offset:1152
    ds_read_b32 v57, v9 offset:804
    s_waitcnt lgkmcnt(0)
    v_min3_f32 v52, v52, v53, v54
    v_min_f32 v52, v52, v55
    v_cmp_gt_f32 vcc, 0, v52
    s_cbranch_vccz L_smok
    s_sleep 1
    s_add_u32 s68, s68, 1
    s_cmp_gt_u32 s68, 200000
    s_cbranch_scc0 L_smw
L_smok:
    v_readfirstlane_b32 s100, v56
    v_readfirstlane_b32 s70, v57
    s_nop 0
    s_xor_b32 s66, s70, 0x80808080
    s_lshr_b32 s73, s66, 8
    s_lshr_b32 s74, s66, 16
    s_lshr_b32 s75, s66, 24
    s_mov_b32 s72, s66
    v_and_b32 v160, v41, v16
    v_and_b32 v161, v41, v17
    v_and_b32 v162, v41, v18
    v_and_b32 v163, v41, v19
    v_lshlrev_b32 v40, 16, v40
    v_mul_f32 v40, v43, v40
    s_waitcnt vmcnt(2)
    buffer_load_dwordx4 v[132:135], v4, s[8:11], s71 offen offset:256 nt
    s_waitcnt lgkmcnt(0)
    v_mfma_f32_16x16x32_bf16 v[20:23], v[32:35], v[112:115], 0
    v_mfma_f32_16x16x32_bf16 v[24:27], v[32:35], v[116:119], 0
    v_mfma_f32_16x16x32_bf16 v[28:31], v[32:35], v[120:123], 0
    v_cvt_pk_bf16_f32 v49, v49, v49
    v_and_b32 v32, v49, v16
    v_and_b32 v33, v49, v17
    v_and_b32 v34, v49, v18
    v_and_b32 v35, v49, v19
    s_mov_b32 s71, 202113024
    s_waitcnt vmcnt(2)
    buffer_load_dwordx4 v[136:139], v4, s[8:11], s71 offen offset:0 nt
    s_waitcnt vmcnt(2)
    buffer_load_dwordx4 v[140:143], v4, s[8:11], s71 offen offset:128 nt
    s_waitcnt vmcnt(3)
    buffer_load_dwordx4 v[144:147], v4, s[8:11], s71 offen offset:256 nt
    s_barrier
    ds_read_b128 v[60:63], v6 offset:1536
    ds_read_b128 v[52:55], v6 offset:2304
    ds_read_b32 v59, v7 offset:1024
    s_waitcnt lgkmcnt(1)
    v_add_f32 v60, v60, v52
    v_add_f32 v61, v61, v53
    v_add_f32 v62, v62, v54
    v_add_f32 v63, v63, v55
    s_waitcnt lgkmcnt(0)
    v_mul_f32 v60, v59, v60
    v_mul_f32 v61, v59, v61
    v_mul_f32 v62, v59, v62
    v_mul_f32 v63, v59, v63
    v_add_f32_dpp v60, v60, v60 quad_perm:[1,0,3,2] row_mask:0xf bank_mask:0xf
    v_add_f32_dpp v61, v61, v61 quad_perm:[1,0,3,2] row_mask:0xf bank_mask:0xf
    v_add_f32_dpp v62, v62, v62 quad_perm:[1,0,3,2] row_mask:0xf bank_mask:0xf
    v_add_f32_dpp v63, v63, v63 quad_perm:[1,0,3,2] row_mask:0xf bank_mask:0xf
    v_add_f32_dpp v60, v60, v60 quad_perm:[2,3,0,1] row_mask:0xf bank_mask:0xf
    v_add_f32_dpp v61, v61, v61 quad_perm:[2,3,0,1] row_mask:0xf bank_mask:0xf
    v_add_f32_dpp v62, v62, v62 quad_perm:[2,3,0,1] row_mask:0xf bank_mask:0xf
    v_add_f32_dpp v63, v63, v63 quad_perm:[2,3,0,1] row_mask:0xf bank_mask:0xf
    v_add_f32_dpp v60, v60, v60 row_half_mirror row_mask:0xf bank_mask:0xf
    v_add_f32_dpp v61, v61, v61 row_half_mirror row_mask:0xf bank_mask:0xf
    v_add_f32_dpp v62, v62, v62 row_half_mirror row_mask:0xf bank_mask:0xf
    v_add_f32_dpp v63, v63, v63 row_half_mirror row_mask:0xf bank_mask:0xf
    v_bfi_b32 v60, v15, s72, v60
    v_bfi_b32 v61, v15, s73, v61
    v_bfi_b32 v62, v15, s74, v62
    v_bfi_b32 v63, v15, s75, v63
    s_mov_b64 exec, s[48:49]
    s_cmp_eq_u32 s100, 0
    s_cbranch_scc0 L_sf1
    buffer_store_dwordx4 v[60:63], v10, s[20:23], 0 offen
L_sd1:
    s_mov_b64 exec, -1
    s_mov_b32 s71, 202506240
    s_waitcnt vmcnt(4)
    buffer_load_dwordx4 v[148:151], v4, s[8:11], s71 offen offset:0 nt
    s_waitcnt vmcnt(5)
    buffer_load_dwordx4 v[152:155], v4, s[8:11], s71 offen offset:128 nt
    s_waitcnt vmcnt(6)
    buffer_load_dwordx4 v[156:159], v4, s[8:11], s71 offen offset:256 nt
    s_barrier
    s_waitcnt vmcnt(7)
    buffer_load_dwordx4 v[64:67], v38, s[16:19], 0 offen nt
    s_waitcnt vmcnt(8)
    buffer_load_dwordx4 v[68:71], v37, s[12:15], 0 offen offset:0 nt
    s_waitcnt vmcnt(9)
    buffer_load_dwordx4 v[72:75], v37, s[12:15], 0 offen offset:1280 nt
    s_waitcnt vmcnt(10)
    buffer_load_dwordx4 v[76:79], v37, s[12:15], 0 offen offset:2560 nt
    s_waitcnt vmcnt(11)
    buffer_load_dwordx4 v[80:83], v37, s[12:15], 0 offen offset:3840 nt
    s_waitcnt vmcnt(11)
    v_mfma_f32_16x16x32_bf16 v[20:23], v[32:35], v[124:127], v[20:23]
    v_mfma_f32_16x16x32_bf16 v[24:27], v[32:35], v[128:131], v[24:27]
    v_mfma_f32_16x16x32_bf16 v[28:31], v[32:35], v[132:135], v[28:31]
    v_cvt_pk_bf16_f32 v50, v50, v50
    v_and_b32 v32, v50, v16
    v_and_b32 v33, v50, v17
    v_and_b32 v34, v50, v18
    v_and_b32 v35, v50, v19
    s_waitcnt vmcnt(8)
    s_nop 0
    v_mfma_f32_16x16x32_bf16 v[20:23], v[32:35], v[136:139], v[20:23]
    v_mfma_f32_16x16x32_bf16 v[24:27], v[32:35], v[140:143], v[24:27]
    v_mfma_f32_16x16x32_bf16 v[28:31], v[32:35], v[144:147], v[28:31]
    v_cvt_pk_bf16_f32 v51, v51, v51
    v_and_b32 v32, v51, v16
    v_and_b32 v33, v51, v17
    v_and_b32 v34, v51, v18
    v_and_b32 v35, v51, v19
    s_waitcnt vmcnt(7)
    s_nop 0
    v_mfma_f32_16x16x32_bf16 v[20:23], v[32:35], v[148:151], v[20:23]
    s_waitcnt vmcnt(6)
    v_mfma_f32_16x16x32_bf16 v[24:27], v[32:35], v[152:155], v[24:27]
    s_waitcnt vmcnt(5)
    v_mfma_f32_16x16x32_bf16 v[28:31], v[32:35], v[156:159], v[28:31]
    s_mov_b64 exec, s[46:47]
    s_nop 2
    ds_write_b128 v5, v[20:23] offset:14080
    s_nop 0
    ds_write_b128 v5, v[24:27] offset:14336
    s_nop 0
    ds_write_b128 v5, v[28:31] offset:14592
    s_mov_b64 exec, -1
    s_waitcnt lgkmcnt(0)
    s_barrier
    ds_read_b128 v[60:63], v6 offset:14080
    ds_read_b128 v[52:55], v6 offset:14848
    ds_read_b32 v59, v7 offset:1056
    s_waitcnt lgkmcnt(1)
    v_add_f32 v60, v60, v52
    v_add_f32 v61, v61, v53
    v_add_f32 v62, v62, v54
    v_add_f32 v63, v63, v55
    s_waitcnt lgkmcnt(0)
    v_mul_f32 v60, v59, v60
    v_mul_f32 v61, v59, v61
    v_mul_f32 v62, v59, v62
    v_mul_f32 v63, v59, v63
    v_add_f32_dpp v60, v60, v60 quad_perm:[1,0,3,2] row_mask:0xf bank_mask:0xf
    v_add_f32_dpp v61, v61, v61 quad_perm:[1,0,3,2] row_mask:0xf bank_mask:0xf
    v_add_f32_dpp v62, v62, v62 quad_perm:[1,0,3,2] row_mask:0xf bank_mask:0xf
    v_add_f32_dpp v63, v63, v63 quad_perm:[1,0,3,2] row_mask:0xf bank_mask:0xf
    v_add_f32_dpp v60, v60, v60 quad_perm:[2,3,0,1] row_mask:0xf bank_mask:0xf
    v_add_f32_dpp v61, v61, v61 quad_perm:[2,3,0,1] row_mask:0xf bank_mask:0xf
    v_add_f32_dpp v62, v62, v62 quad_perm:[2,3,0,1] row_mask:0xf bank_mask:0xf
    v_add_f32_dpp v63, v63, v63 quad_perm:[2,3,0,1] row_mask:0xf bank_mask:0xf
    v_add_f32_dpp v60, v60, v60 row_half_mirror row_mask:0xf bank_mask:0xf
    v_add_f32_dpp v61, v61, v61 row_half_mirror row_mask:0xf bank_mask:0xf
    v_add_f32_dpp v62, v62, v62 row_half_mirror row_mask:0xf bank_mask:0xf
    v_add_f32_dpp v63, v63, v63 row_half_mirror row_mask:0xf bank_mask:0xf
    v_bfi_b32 v60, v15, s72, v60
    v_bfi_b32 v61, v15, s73, v61
    v_bfi_b32 v62, v15, s74, v62
    v_bfi_b32 v63, v15, s75, v63
    s_mov_b64 exec, s[48:49]
    s_cmp_eq_u32 s100, 0
    s_cbranch_scc0 L_sf2
    buffer_store_dwordx4 v[60:63], v10, s[20:23], s34 offen
L_sd2:
    s_mov_b64 exec, -1
    s_cmp_lt_u32 s29, 30
    s_cbranch_scc0 L_fin
    s_mov_b32 s68, 0
    s_waitcnt vmcnt(4)
    v_mfma_f32_16x16x32_bf16 v[24:27], v[160:163], v[64:67], 0
    s_nop 7
    v_mul_f32 v24, v43, v24
    v_mul_f32 v25, v43, v25
    v_mul_f32 v26, v43, v26
    v_mul_f32 v27, v43, v27
L_h1:
    buffer_load_dwordx4 v[56:59], v14, s[20:23], 0 offen sc1 nt
    s_add_u32 s68, s68, 1
    s_cmp_gt_u32 s68, 200000
    s_cbranch_scc1 L_h1_giveup
    s_waitcnt vmcnt(0)
    v_perm_b32 v52, v57, v56, s30
    v_perm_b32 v53, v59, v58, s31
    v_or_b32 v52, v52, v53
    v_cmp_ne_u32 vcc, s66, v52
    s_cbranch_vccnz L_h1
L_h1_done:
    v_add_f32_dpp v56, v56, v56 quad_perm:[1,0,3,2] row_mask:0xf bank_mask:0xf
    v_add_f32_dpp v57, v57, v57 quad_perm:[1,0,3,2] row_mask:0xf bank_mask:0xf
    v_add_f32_dpp v58, v58, v58 quad_perm:[1,0,3,2] row_mask:0xf bank_mask:0xf
    v_add_f32_dpp v59, v59, v59 quad_perm:[1,0,3,2] row_mask:0xf bank_mask:0xf
    v_add_f32_dpp v56, v56, v56 quad_perm:[2,3,0,1] row_mask:0xf bank_mask:0xf
    v_add_f32_dpp v57, v57, v57 quad_perm:[2,3,0,1] row_mask:0xf bank_mask:0xf
    v_add_f32_dpp v58, v58, v58 quad_perm:[2,3,0,1] row_mask:0xf bank_mask:0xf
    v_add_f32_dpp v59, v59, v59 quad_perm:[2,3,0,1] row_mask:0xf bank_mask:0xf
    v_add_f32_dpp v56, v56, v56 row_half_mirror row_mask:0xf bank_mask:0xf
    v_add_f32_dpp v57, v57, v57 row_half_mirror row_mask:0xf bank_mask:0xf
    v_add_f32_dpp v58, v58, v58 row_half_mirror row_mask:0xf bank_mask:0xf
    v_add_f32_dpp v59, v59, v59 row_half_mirror row_mask:0xf bank_mask:0xf
    v_add_f32_dpp v56, v56, v56 row_mirror row_mask:0xf bank_mask:0xf
    v_add_f32_dpp v57, v57, v57 row_mirror row_mask:0xf bank_mask:0xf
    v_add_f32_dpp v58, v58, v58 row_mirror row_mask:0xf bank_mask:0xf
    v_add_f32_dpp v59, v59, v59 row_mirror row_mask:0xf bank_mask:0xf
    v_cvt_pk_bf16_f32 v56, v56, v56
    v_cvt_pk_bf16_f32 v57, v57, v57
    v_cvt_pk_bf16_f32 v58, v58, v58
    v_cvt_pk_bf16_f32 v59, v59, v59
    v_and_b32 v32, v56, v16
    v_and_b32 v33, v56, v17
    v_and_b32 v34, v56, v18
    v_and_b32 v35, v56, v19
    v_and_b32 v44, v57, v16
    v_and_b32 v45, v57, v17
    v_and_b32 v46, v57, v18
    v_and_b32 v47, v57, v19
    v_mfma_f32_16x16x32_bf16 v[24:27], v[32:35], v[68:71], v[24:27]
    v_and_b32 v48, v58, v16
    v_and_b32 v49, v58, v17
    v_and_b32 v50, v58, v18
    v_and_b32 v51, v58, v19
    v_mfma_f32_16x16x32_bf16 v[24:27], v[44:47], v[72:75], v[24:27]
    v_and_b32 v52, v59, v16
    v_and_b32 v53, v59, v17
    v_and_b32 v54, v59, v18
    v_and_b32 v55, v59, v19
    v_mfma_f32_16x16x32_bf16 v[24:27], v[48:51], v[76:79], v[24:27]
    s_nop 0
    v_mfma_f32_16x16x32_bf16 v[24:27], v[52:55], v[80:83], v[24:27]
    v_mov_b32 v58, 1.0
    v_mov_b32 v59, 0x423c0000
    s_cmp_lt_u32 s67, 4
    s_mov_b32 exec_hi, 0
    s_nop 3
    ds_write_b128 v12, v[24:27] offset:26688
    s_mov_b64 exec, -1
    s_waitcnt lgkmcnt(0)
    s_barrier
    s_cbranch_scc0 L_fin
    ds_read_b128 v[60:63], v36 offset:26688
    s_waitcnt lgkmcnt(0)
    s_nop 1
    v_permlane32_swap_b32 v60, v61
    v_permlane32_swap_b32 v62, v63
    v_add_f32 v60, v60, v61
    v_add_f32 v62, v62, v63
    s_nop 1
    v_permlane16_swap_b32 v60, v62
    v_add_f32 v60, v60, v62
    s_nop 1
    v_add_f32_dpp v58, v60, v60 row_ror:8 row_mask:0xf bank_mask:0x3
    buffer_atomic_add_f32 v58, v13, s[20:23], 0 offen sc0 sc1
    v_add_f32_dpp v61, v60, v60 row_ror:8 row_mask:0xf bank_mask:0xf
    v_add_f32 v61, v61, v40
    s_waitcnt vmcnt(0)
    v_cmp_eq_f32 vcc, v59, v58
    v_add_f32 v61, v61, v58
    v_cvt_pk_bf16_f32 v61, v61, v61
    s_lshr_b64 vcc, vcc, 8
    s_and_b64 exec, vcc, s[32:33]
    s_cbranch_execz L_fin
    global_store_short v164, v61, s[58:59]
    s_endpgm
L_h1_giveup:
    s_waitcnt vmcnt(0)
    s_nop 1
    s_branch L_h1_done
L_sf2:
    buffer_store_dwordx4 v[60:63], v10, s[20:23], s34 offen sc1
    s_branch L_sd2
L_sf1:
    buffer_store_dwordx4 v[60:63], v10, s[20:23], 0 offen sc1
    s_branch L_sd1
L_ctl:
    s_sub_u32 s3, s67, 8
    s_cmp_eq_u32 s3, 3
    s_cbranch_scc0 L_noli
    v_lshlrev_b32 v9, 2, v1
    v_mov_b32 v52, -1.0
    ds_write_b32 v9, v52 offset:768
    s_waitcnt lgkmcnt(0)
L_noli:
    s_load_dwordx16 s[36:51], s[0:1], 0
    s_load_dwordx8 s[52:59], s[0:1], 64
    s_load_dwordx4 s[60:63], s[0:1], 96
    s_barrier
    s_setprio 2
    s_and_b32 s28, s2, 7
    s_lshr_b32 s29, s2, 3
    s_mul_i32 s101, s29, 52
    s_lshr_b32 s101, s101, 8
    s_min_u32 s101, s101, 5
    s_lshl_b32 s64, s28, 2
    s_and_b32 s68, s29, 1
    s_add_u32 s64, s64, s68
    s_cmp_eq_u32 s3, 3
    s_cbranch_scc1 L_gate
    s_mul_i32 s68, s65, 983040
    s_and_b32 s69, s2, 31
    s_mul_i32 s69, s69, 384
    s_add_u32 s68, s68, s69
    s_lshl_b32 s69, s3, 7
    s_add_u32 s68, s68, s69
    s_mul_i32 s71, s29, 61440
    s_add_u32 s71, s71, s69
    s_mul_i32 s69, s28, 384
    s_add_u32 s71, s71, s69
    s_mov_b32 s14, 970880
    s_mov_b32 s15, 0x20000
    s_mov_b32 s18, 58496
    s_mov_b32 s19, 0x20000
    s_mov_b32 s34, 1280
    s_mov_b32 s35, 0x20000
    v_mul_u32_u24 v5, 122880, v2
    v_lshl_add_u32 v5, v3, 4, v5
    v_mul_u32_u24 v6, 9216, v2
    v_lshl_add_u32 v6, v3, 4, v6
    v_add_u32 v14, 6144, v6
    v_mul_u32_u24 v7, 20, v2
    s_mul_i32 s27, s65, 160
    v_add_u32 v7, s27, v7
    v_mul_u32_u24 v8, 6, v2
    s_mul_i32 s27, s29, 40
    v_add_u32 v8, s27, v8
    s_waitcnt lgkmcnt(0)
    s_add_u32 s12, s42, s68
    s_addc_u32 s13, s43, 0
    s_and_b32 s13, s13, 0xffff
    s_add_u32 s16, s48, s71
    s_addc_u32 s17, s49, 0
    s_and_b32 s17, s17, 0xffff
    s_mov_b32 s32, s36
    s_and_b32 s33, s37, 0xffff
    s_mov_b32 s71, 0
    buffer_load_dwordx4 v[64:67], v5, s[12:15], s71 offen nt
    s_mov_b32 s71, 12288
    buffer_load_dwordx4 v[68:71], v5, s[12:15], s71 offen nt
    s_mov_b32 s71, 24576
    buffer_load_dwordx4 v[72:75], v5, s[12:15], s71 offen nt
    s_mov_b32 s71, 36864
    buffer_load_dwordx4 v[76:79], v5, s[12:15], s71 offen nt
    s_mov_b32 s71, 49152
    buffer_load_dwordx4 v[80:83], v5, s[12:15], s71 offen nt
    s_mov_b32 s71, 61440
    buffer_load_dwordx4 v[84:87], v5, s[12:15], s71 offen nt
    s_mov_b32 s71, 73728
    buffer_load_dwordx4 v[88:91], v5, s[12:15], s71 offen nt
    s_mov_b32 s71, 86016
    buffer_load_dwordx4 v[92:95], v5, s[12:15], s71 offen nt
    s_mov_b32 s71, 98304
    buffer_load_dwordx4 v[96:99], v5, s[12:15], s71 offen nt
    s_mov_b32 s71, 110592
    buffer_load_dwordx4 v[100:103], v5, s[12:15], s71 offen nt
    buffer_load_dwordx4 v[104:107], v6, s[16:19], 0 offen nt
    buffer_load_dwordx4 v[108:111], v6, s[16:19], 0 offen offset:3072 nt
    buffer_load_dwordx4 v[112:115], v14, s[16:19], 0 offen nt
    buffer_load_dwordx4 v[116:119], v7, s[32:35], 0 offen
    buffer_load_dword v120, v7, s[32:35], 0 offen offset:16
    buffer_load_ushort v124, v8, s[32:35], 0 offen offset:0
    buffer_load_ushort v125, v8, s[32:35], 0 offen offset:2
    buffer_load_ushort v126, v8, s[32:35], 0 offen offset:4
    s_mov_b32 s20, s62
    s_and_b32 s21, s63, 0xffff
    s_mov_b32 s22, 1048576
    s_mov_b32 s23, 0x20000
    s_mov_b32 s30, 0x0c0c0400
    s_mov_b32 s31, 0x04000c0c
    v_and_b32 v5, 1, v1
    v_lshlrev_b32 v5, 4, v5
    v_mov_b32 v6, 0xffff
    v_lshlrev_b32 v6, v5, v6
    v_lshrrev_b32 v5, 1, v3
    v_cmp_eq_u32 vcc, 0, v5
    s_nop 1
    v_cndmask_b32 v16, 0, v6, vcc
    v_cmp_eq_u32 vcc, 1, v5
    s_nop 1
    v_cndmask_b32 v17, 0, v6, vcc
    v_cmp_eq_u32 vcc, 2, v5
    s_nop 1
    v_cndmask_b32 v18, 0, v6, vcc
    v_cmp_eq_u32 vcc, 3, v5
    s_nop 1
    v_cndmask_b32 v19, 0, v6, vcc
    v_mov_b32 v15, 0xff
    s_and_b32 s68, s29, 3
    s_lshl2_add_u32 s68, s28, s68
    s_lshl_b32 s68, s68, 3
    s_add_u32 s68, s68, s65
    s_mul_i32 s68, s68, 768
    s_add_u32 s68, s68, 4096
    s_mul_i32 s69, s28, 24576
    s_lshl_b32 s27, s29, 4
    s_add_u32 s69, s69, s27
    s_add_u32 s69, s69, 262144
    v_and_b32 v10, 16, v1
    v_lshl_add_u32 v10, v3, 5, v10
    s_lshl_b32 s27, s3, 8
    v_add_u32 v10, s27, v10
    v_add_u32 v9, s68, v10
    v_lshl_add_u32 v10, v10, 5, s69
    v_cmp_gt_u32 vcc, 32, v1
    s_nop 1
    v_cndmask_b32 v9, v10, v9, vcc
    v_lshrrev_b32 v10, 4, v1
    v_mul_u32_u24 v11, 768, v10
    v_and_b32 v12, 15, v1
    v_lshl_add_u32 v11, v12, 4, v11
    s_mul_i32 s69, s64, 6144
    s_add_u32 s69, s69, s27
    s_add_u32 s69, s69, 4096
    v_add_u32 v11, s69, v11
    s_movk_i32 s25, 12288
    v_and_b32 v13, 1, v10
    v_lshlrev_b32 v13, 1, v13
    v_lshrrev_b32 v14, 1, v10
    v_add_u32 v13, v13, v14
    v_lshl_add_u32 v13, v12, 2, v13
    v_lshlrev_b32 v13, 1, v13
    s_lshl_b32 s69, s3, 7
    v_add_u32 v13, s69, v13
    v_mov_b32 v6, 0
    s_mov_b32 s68, 0
L_tgw:
    ds_read_b64 v[52:53], v6 offset:800
    s_waitcnt lgkmcnt(0)
    v_cmp_gt_f32 vcc, 0, v52
    s_cbranch_vccz L_tgok
    s_sleep 1
    s_add_u32 s68, s68, 1
    s_cmp_gt_u32 s68, 200000
    s_cbranch_scc0 L_tgw
L_tgok:
    v_readfirstlane_b32 s70, v53
    s_nop 0
    s_mov_b32 s66, s70
    s_lshr_b32 s73, s66, 8
    s_lshr_b32 s74, s66, 16
    s_lshr_b32 s75, s66, 24
    s_mov_b32 s72, s66
    s_mov_b32 s68, 0x01000100
    s_mov_b32 s69, 0x03020302
    s_waitcnt vmcnt(0)
    v_perm_b32 v60, v116, v116, s68
    v_and_b32 v52, v60, v16
    v_and_b32 v53, v60, v17
    v_and_b32 v54, v60, v18
    v_and_b32 v55, v60, v19
    s_nop 1
    v_mfma_f32_16x16x32_bf16 v[32:35], v[52:55], v[64:67], 0
    v_perm_b32 v60, v116, v116, s69
    v_and_b32 v56, v60, v16
    v_and_b32 v57, v60, v17
    v_and_b32 v58, v60, v18
    v_and_b32 v59, v60, v19
    s_nop 1
    v_mfma_f32_16x16x32_bf16 v[32:35], v[56:59], v[68:71], v[32:35]
    v_perm_b32 v60, v117, v117, s68
    v_and_b32 v52, v60, v16
    v_and_b32 v53, v60, v17
    v_and_b32 v54, v60, v18
    v_and_b32 v55, v60, v19
    s_nop 1
    v_mfma_f32_16x16x32_bf16 v[32:35], v[52:55], v[72:75], v[32:35]
    v_perm_b32 v60, v117, v117, s69
    v_and_b32 v56, v60, v16
    v_and_b32 v57, v60, v17
    v_and_b32 v58, v60, v18
    v_and_b32 v59, v60, v19
    s_nop 1
    v_mfma_f32_16x16x32_bf16 v[32:35], v[56:59], v[76:79], v[32:35]
    v_perm_b32 v60, v118, v118, s68
    v_and_b32 v52, v60, v16
    v_and_b32 v53, v60, v17
    v_and_b32 v54, v60, v18
    v_and_b32 v55, v60, v19
    s_nop 1
    v_mfma_f32_16x16x32_bf16 v[32:35], v[52:55], v[80:83], v[32:35]
    v_perm_b32 v60, v118, v118, s69
    v_and_b32 v56, v60, v16
    v_and_b32 v57, v60, v17
    v_and_b32 v58, v60, v18
    v_and_b32 v59, v60, v19
    s_nop 1
    v_mfma_f32_16x16x32_bf16 v[32:35], v[56:59], v[84:87], v[32:35]
    v_perm_b32 v60, v119, v119, s68
    v_and_b32 v52, v60, v16
    v_and_b32 v53, v60, v17
    v_and_b32 v54, v60, v18
    v_and_b32 v55, v60, v19
    s_nop 1
    v_mfma_f32_16x16x32_bf16 v[32:35], v[52:55], v[88:91], v[32:35]
    v_perm_b32 v60, v119, v119, s69
    v_and_b32 v56, v60, v16
    v_and_b32 v57, v60, v17
    v_and_b32 v58, v60, v18
    v_and_b32 v59, v60, v19
    s_nop 1
    v_mfma_f32_16x16x32_bf16 v[32:35], v[56:59], v[92:95], v[32:35]
    v_perm_b32 v60, v120, v120, s68
    v_and_b32 v52, v60, v16
    v_and_b32 v53, v60, v17
    v_and_b32 v54, v60, v18
    v_and_b32 v55, v60, v19
    s_nop 1
    v_mfma_f32_16x16x32_bf16 v[32:35], v[52:55], v[96:99], v[32:35]
    v_perm_b32 v60, v120, v120, s69
    v_and_b32 v56, v60, v16
    v_and_b32 v57, v60, v17
    v_and_b32 v58, v60, v18
    v_and_b32 v59, v60, v19
    s_nop 1
    v_mfma_f32_16x16x32_bf16 v[32:35], v[56:59], v[100:103], v[32:35]
    v_perm_b32 v60, v124, v124, s68
    v_and_b32 v52, v60, v16
    v_and_b32 v53, v60, v17
    v_and_b32 v54, v60, v18
    v_and_b32 v55, v60, v19
    s_nop 1
    v_mfma_f32_16x16x32_bf16 v[36:39], v[52:55], v[104:107], 0
    v_perm_b32 v60, v125, v125, s68
    v_and_b32 v56, v60, v16
    v_and_b32 v57, v60, v17
    v_and_b32 v58, v60, v18
    v_and_b32 v59, v60, v19
    s_nop 1
    v_mfma_f32_16x16x32_bf16 v[36:39], v[56:59], v[108:111], v[36:39]
    v_perm_b32 v60, v126, v126, s68
    v_and_b32 v52, v60, v16
    v_and_b32 v53, v60, v17
    v_and_b32 v54, v60, v18
    v_and_b32 v55, v60, v19
    s_nop 1
    v_mfma_f32_16x16x32_bf16 v[36:39], v[52:55], v[112:115], v[36:39]
    s_nop 7
    v_permlane32_swap_b32 v32, v36
    v_permlane32_swap_b32 v33, v37
    v_permlane32_swap_b32 v34, v38
    v_permlane32_swap_b32 v35, v39
    v_add_f32_dpp v32, v36, v32 row_ror:8 row_mask:0xf bank_mask:0xf
    v_add_f32_dpp v33, v37, v33 row_ror:8 row_mask:0xf bank_mask:0xf
    v_add_f32_dpp v34, v38, v34 row_ror:8 row_mask:0xf bank_mask:0xf
    v_add_f32_dpp v35, v39, v35 row_ror:8 row_mask:0xf bank_mask:0xf
    v_bfi_b32 v32, v15, s72, v32
    v_bfi_b32 v33, v15, s73, v33
    v_bfi_b32 v34, v15, s74, v34
    v_bfi_b32 v35, v15, s75, v35
    s_mov_b32 exec_lo, 0x00ff00ff
    s_mov_b32 exec_hi, 0x00ff00ff
    buffer_store_dwordx4 v[32:35], v9, s[20:23], 0 offen
    s_mov_b64 exec, -1
    s_mov_b32 s26, 0
    s_mov_b32 s68, 0
L_qpoll:
    buffer_load_dwordx4 v[64:67], v11, s[20:23], 0 offen sc1 nt
    buffer_load_dwordx4 v[68:71], v11, s[20:23], 0 offen offset:3072 sc1 nt
    buffer_load_dwordx4 v[72:75], v11, s[20:23], s25 offen sc1 nt
    buffer_load_dwordx4 v[76:79], v11, s[20:23], s25 offen offset:3072 sc1 nt
    s_waitcnt vmcnt(0)
    ds_read_b32 v63, v6 offset:780
    v_perm_b32 v60, v65, v64, s30
    v_perm_b32 v61, v67, v66, s31
    v_or_b32 v60, v60, v61
    v_xor_b32 v62, s66, v60
    v_perm_b32 v60, v69, v68, s30
    v_perm_b32 v61, v71, v70, s31
    v_or_b32 v60, v60, v61
    v_xor_b32 v60, s66, v60
    v_or_b32 v62, v62, v60
    v_perm_b32 v60, v73, v72, s30
    v_perm_b32 v61, v75, v74, s31
    v_or_b32 v60, v60, v61
    v_xor_b32 v60, s66, v60
    v_or_b32 v62, v62, v60
    v_perm_b32 v60, v77, v76, s30
    v_perm_b32 v61, v79, v78, s31
    v_or_b32 v60, v60, v61
    v_xor_b32 v60, s66, v60
    v_or_b32 v62, v62, v60
    s_waitcnt lgkmcnt(0)
    v_readfirstlane_b32 s100, v63
    s_nop 0
    s_cmp_eq_u32 s100, 1.0
    s_cbranch_scc0 L_nr1
    s_cmp_eq_u32 s26, 0
    s_cbranch_scc0 L_nr1
    s_mov_b32 s26, 1
    s_mov_b32 exec_lo, 0x00ff00ff
    s_mov_b32 exec_hi, 0x00ff00ff
    buffer_store_dwordx4 v[32:35], v9, s[20:23], 0 offen sc1
    s_mov_b64 exec, -1
L_nr1:
    v_cmp_ne_u32 vcc, 0, v62
    s_cbranch_vccz L_qok
    s_add_u32 s68, s68, 1
    s_cmp_gt_u32 s68, 200000
    s_cbranch_scc0 L_qpoll
L_qok:
    s_movk_i32 s68, 0x80
    v_bfi_b32 v64, v15, s68, v64
    v_bfi_b32 v65, v15, s68, v65
    v_bfi_b32 v66, v15, s68, v66
    v_bfi_b32 v67, v15, s68, v67
    v_bfi_b32 v68, v15, s68, v68
    v_bfi_b32 v69, v15, s68, v69
    v_bfi_b32 v70, v15, s68, v70
    v_bfi_b32 v71, v15, s68, v71
    v_bfi_b32 v72, v15, s68, v72
    v_bfi_b32 v73, v15, s68, v73
    v_bfi_b32 v74, v15, s68, v74
    v_bfi_b32 v75, v15, s68, v75
    v_bfi_b32 v76, v15, s68, v76
    v_bfi_b32 v77, v15, s68, v77
    v_bfi_b32 v78, v15, s68, v78
    v_bfi_b32 v79, v15, s68, v79
    v_add_f32 v64, v64, v68
    v_add_f32 v65, v65, v69
    v_add_f32 v66, v66, v70
    v_add_f32 v67, v67, v71
    v_permlane32_swap_b32 v64, v65
    s_nop 0
    v_permlane32_swap_b32 v66, v67
    v_add_f32 v64, v64, v65
    v_add_f32 v66, v66, v67
    s_nop 1
    v_permlane16_swap_b32 v64, v66
    v_add_f32 v64, v64, v66
    v_cvt_pk_bf16_f32 v64, v64, v64
    ds_write_b16 v13, v64 offset:0
    v_add_f32 v72, v72, v76
    v_add_f32 v73, v73, v77
    v_add_f32 v74, v74, v78
    v_add_f32 v75, v75, v79
    v_permlane32_swap_b32 v72, v73
    s_nop 0
    v_permlane32_swap_b32 v74, v75
    v_add_f32 v72, v72, v73
    v_add_f32 v74, v74, v75
    s_nop 1
    v_permlane16_swap_b32 v72, v74
    v_add_f32 v72, v72, v74
    v_cvt_pk_bf16_f32 v72, v72, v72
    ds_write_b16 v13, v72 offset:384
    s_lshl_b32 s68, s3, 2
    v_mov_b32 v5, s68
    ds_write_b32 v5, v6 offset:768
    s_mov_b32 s68, 0
L_mw:
    ds_read_b32 v63, v6 offset:780
    s_waitcnt lgkmcnt(0)
    v_cmp_gt_f32 vcc, 0, v63
    s_cbranch_vccz L_mok
    s_sleep 1
    s_add_u32 s68, s68, 1
    s_cmp_gt_u32 s68, 200000
    s_cbranch_scc0 L_mw
L_mok:
    v_readfirstlane_b32 s100, v63
    s_nop 0
    s_cmp_eq_u32 s100, 1.0
    s_cbranch_scc0 L_nr2
    s_cmp_eq_u32 s26, 0
    s_cbranch_scc0 L_nr2
    s_mov_b32 s26, 1
    s_mov_b32 exec_lo, 0x00ff00ff
    s_mov_b32 exec_hi, 0x00ff00ff
    buffer_store_dwordx4 v[32:35], v9, s[20:23], 0 offen sc1
    s_mov_b64 exec, -1
L_nr2:
    s_branch L_ffn
L_gate:
    s_getreg_b32 s25, hwreg(HW_REG_XCC_ID)
    s_and_b32 s25, s25, 15
    s_waitcnt lgkmcnt(0)
    s_lshl_b32 s71, s28, 7
    s_load_dword s70, s[62:63], s71
    s_mov_b32 s20, s62
    s_and_b32 s21, s63, 0xffff
    s_mov_b32 s22, 1048576
    s_mov_b32 s23, 0x20000
    s_mov_b32 s30, 0x0c0c0400
    s_mov_b32 s31, 0x04000c0c
    v_mul_u32_u24 v7, 20, v1
    s_lshl_b32 s27, s28, 7
    s_add_u32 s27, s27, 2048
    v_and_b32 v11, 31, v1
    v_lshl_add_u32 v8, v11, 2, s27
    s_lshl_b32 s26, s29, 2
    s_add_u32 s26, s26, s27
    v_mov_b32 v4, s26
    s_waitcnt lgkmcnt(0)
    s_and_b32 s72, s70, 0x7f7f7f7f
    s_add_u32 s72, s72, 0x01010101
    s_and_b32 s73, s70, 0x80808080
    s_xor_b32 s70, s72, s73
    s_mov_b32 s66, s70
    s_lshr_b32 s73, s66, 8
    s_lshr_b32 s74, s66, 16
    s_lshr_b32 s75, s66, 24
    s_mov_b32 s72, s66
    v_mov_b32 v54, 0
    v_mov_b32 v55, s70
    ds_write_b64 v54, v[54:55] offset:800
    s_and_b32 s27, s66, 0xfffffff0
    s_or_b32 s27, s27, s25
    v_mov_b32 v52, s27
    s_mov_b64 exec, 1
    buffer_store_dword v52, v4, s[20:23], 0 offen
    s_mov_b64 exec, -1
    s_cmp_eq_u32 s2, 255
    s_cbranch_scc0 L_noinit
    v_mov_b32 v56, 0
    v_mov_b32 v57, 0
    v_mov_b32 v58, 0
    v_mov_b32 v59, 0
    v_lshlrev_b32 v53, 4, v1
    v_add_u32 v53, 589824, v53
    s_mov_b32 s71, 0
    buffer_store_dwordx4 v[56:59], v53, s[20:23], s71 offen sc1
    s_mov_b32 s71, 1024
    buffer_store_dwordx4 v[56:59], v53, s[20:23], s71 offen sc1
    s_mov_b32 s71, 2048
    buffer_store_dwordx4 v[56:59], v53, s[20:23], s71 offen sc1
    s_mov_b32 s71, 3072
    buffer_store_dwordx4 v[56:59], v53, s[20:23], s71 offen sc1
    s_mov_b32 s71, 4096
    buffer_store_dwordx4 v[56:59], v53, s[20:23], s71 offen sc1
    s_mov_b32 s71, 5120
    buffer_store_dwordx4 v[56:59], v53, s[20:23], s71 offen sc1
    s_mov_b32 s71, 6144
    buffer_store_dwordx4 v[56:59], v53, s[20:23], s71 offen sc1
    s_mov_b32 s71, 7168
    buffer_store_dwordx4 v[56:59], v53, s[20:23], s71 offen sc1
    s_mov_b32 s71, 8192
    buffer_store_dwordx4 v[56:59], v53, s[20:23], s71 offen sc1
    s_mov_b32 s71, 9216
    buffer_store_dwordx4 v[56:59], v53, s[20:23], s71 offen sc1
    s_waitcnt vmcnt(0)
    v_mov_b32 v53, 1
    s_mov_b64 exec, 1
    global_store_dword v56, v53, s[60:61] sc1
    s_mov_b64 exec, -1
L_noinit:
    global_load_dwordx4 v[64:67], v7, s[36:37]
    global_load_dword v68, v7, s[36:37] offset:16
    global_load_dwordx4 v[72:75], v7, s[56:57]
    global_load_dword v76, v7, s[56:57] offset:16
    v_mov_b32 v6, 0
    s_waitcnt vmcnt(0)
    v_mov_b32 v52, 0
    v_lshlrev_b32 v53, 16, v64
    v_and_b32 v54, 0xffff0000, v64
    v_lshlrev_b32 v55, 16, v72
    v_and_b32 v56, 0xffff0000, v72
    v_mul_f32 v53, v53, v55
    v_mul_f32 v54, v54, v56
    v_cvt_pk_bf16_f32 v53, v53, v54
    v_lshlrev_b32 v54, 16, v53
    v_and_b32 v53, 0xffff0000, v53
    v_add_f32 v52, v52, v54
    v_add_f32 v52, v52, v53
    v_lshlrev_b32 v53, 16, v65
    v_and_b32 v54, 0xffff0000, v65
    v_lshlrev_b32 v55, 16, v73
    v_and_b32 v56, 0xffff0000, v73
    v_mul_f32 v53, v53, v55
    v_mul_f32 v54, v54, v56
    v_cvt_pk_bf16_f32 v53, v53, v54
    v_lshlrev_b32 v54, 16, v53
    v_and_b32 v53, 0xffff0000, v53
    v_add_f32 v52, v52, v54
    v_add_f32 v52, v52, v53
    v_lshlrev_b32 v53, 16, v66
    v_and_b32 v54, 0xffff0000, v66
    v_lshlrev_b32 v55, 16, v74
    v_and_b32 v56, 0xffff0000, v74
    v_mul_f32 v53, v53, v55
    v_mul_f32 v54, v54, v56
    v_cvt_pk_bf16_f32 v53, v53, v54
    v_lshlrev_b32 v54, 16, v53
    v_and_b32 v53, 0xffff0000, v53
    v_add_f32 v52, v52, v54
    v_add_f32 v52, v52, v53
    v_lshlrev_b32 v53, 16, v67
    v_and_b32 v54, 0xffff0000, v67
    v_lshlrev_b32 v55, 16, v75
    v_and_b32 v56, 0xffff0000, v75
    v_mul_f32 v53, v53, v55
    v_mul_f32 v54, v54, v56
    v_cvt_pk_bf16_f32 v53, v53, v54
    v_lshlrev_b32 v54, 16, v53
    v_and_b32 v53, 0xffff0000, v53
    v_add_f32 v52, v52, v54
    v_add_f32 v52, v52, v53
    v_lshlrev_b32 v53, 16, v68
    v_and_b32 v54, 0xffff0000, v68
    v_lshlrev_b32 v55, 16, v76
    v_and_b32 v56, 0xffff0000, v76
    v_mul_f32 v53, v53, v55
    v_mul_f32 v54, v54, v56
    v_cvt_pk_bf16_f32 v53, v53, v54
    v_lshlrev_b32 v54, 16, v53
    v_and_b32 v53, 0xffff0000, v53
    v_add_f32 v52, v52, v54
    v_add_f32 v52, v52, v53
    s_nop 1
    v_add_f32_dpp v52, v52, v52 quad_perm:[1,0,3,2] row_mask:0xf bank_mask:0xf
    s_nop 1
    v_add_f32_dpp v52, v52, v52 quad_perm:[2,3,0,1] row_mask:0xf bank_mask:0xf
    s_nop 1
    v_add_f32_dpp v52, v52, v52 row_half_mirror row_mask:0xf bank_mask:0xf
    s_nop 1
    v_add_f32_dpp v52, v52, v52 row_mirror row_mask:0xf bank_mask:0xf
    v_mov_b32 v53, v52
    s_nop 1
    v_permlane16_swap_b32 v52, v53
    v_add_f32 v52, v52, v53
    v_mov_b32 v53, v52
    s_nop 1
    v_permlane32_swap_b32 v52, v53
    v_add_f32 v52, v52, v53
    v_cvt_pk_bf16_f32 v52, v52, v52
    v_and_b32 v52, 0xffff0000, v52
    v_mul_f32 v52, 0xbfb8aa3b, v52
    v_exp_f32 v52, v52
    s_nop 0
    v_add_f32 v52, 1.0, v52
    v_rcp_f32 v52, v52
    s_nop 0
    v_cvt_pk_bf16_f32 v52, v52, v52
    v_and_b32 v46, 0xffff0000, v52
    v_sub_f32 v47, 1.0, v46
    v_cvt_pk_bf16_f32 v47, v47, v47
    v_and_b32 v47, 0xffff0000, v47
    ds_write_b64 v6, v[46:47] offset:1088
    s_mov_b32 s68, 0
L_gq0:
    ds_read_b96 v[52:54], v6 offset:768
    s_waitcnt lgkmcnt(0)
    v_min3_f32 v52, v52, v53, v54
    v_cmp_gt_f32 vcc, 0, v52
    s_cbranch_vccz L_gq0ok
    s_sleep 2
    s_add_u32 s68, s68, 1
    s_cmp_gt_u32 s68, 60
    s_cbranch_scc0 L_gq0
L_gq0ok:
    s_mov_b32 s68, 0
    s_mov_b32 s100, 0
L_xp1:
    buffer_load_dword v53, v8, s[20:23], 0 offen sc1 nt
    global_load_dword v54, v6, s[60:61] sc1
    s_waitcnt vmcnt(0)
    v_cmp_ne_u32 vcc, s27, v53
    s_cbranch_vccz L_xp1ok
    s_sleep 16
    s_add_u32 s68, s68, 1
    s_cmp_lt_u32 s68, 8
    s_cbranch_scc1 L_xp1
    s_mov_b32 s100, 1.0
    v_mov_b32 v52, s27
    s_mov_b64 exec, 1
    buffer_store_dword v52, v4, s[20:23], 0 offen sc1
    s_mov_b64 exec, -1
L_xp1ok:
    v_mov_b32 v55, s100
    ds_write_b32 v6, v55 offset:780
    s_mov_b32 s68, 0
    s_branch L_xp2
L_xpoll:
    buffer_load_dword v53, v8, s[20:23], 0 offen sc1 nt
    global_load_dword v54, v6, s[60:61] sc1
    s_waitcnt vmcnt(0)
L_xp2:
    v_xor_b32 v55, s27, v53
    v_cmp_eq_u32 s[4:5], 0, v54
    v_cmp_lt_u32 vcc, 15, v55
    s_nop 0
    s_or_b64 vcc, vcc, s[4:5]
    s_cbranch_vccz L_xok
    s_sleep 16
    s_add_u32 s68, s68, 1
    s_cmp_gt_u32 s68, 200000
    s_cbranch_scc0 L_xpoll
L_xok:
    s_cmp_eq_u32 s29, 0
    s_cbranch_scc0 L_noep
    s_lshl_b32 s71, s28, 7
    v_mov_b32 v54, s70
    s_mov_b64 exec, 1
    buffer_store_dword v54, v6, s[20:23], s71 offen
    s_mov_b64 exec, -1
L_noep:
L_ffn:
    s_lshl_b32 s68, s101, 2
    s_add_u32 s68, s68, s3
    s_lshl_b32 s69, s68, 10
    s_mul_i32 s27, s28, 24576
    s_add_u32 s69, s69, s27
    s_add_u32 s69, s69, 262144
    v_lshl_add_u32 v11, v1, 4, s69
    s_lshl_b32 s69, s68, 4
    s_mul_i32 s27, s28, 384
    s_add_u32 s69, s69, s27
    v_lshrrev_b32 v10, 4, v1
    v_lshl_add_u32 v12, v10, 2, s69
    global_load_dword v44, v12, s[50:51]
    s_lshl_b32 s69, s3, 5
    v_lshl_add_u32 v13, v10, 3, s69
    s_mov_b32 s68, 0
L_hpoll:
    buffer_load_dwordx4 v[52:55], v11, s[20:23], 0 offen sc1 nt
    s_waitcnt vmcnt(0)
    v_perm_b32 v60, v53, v52, s30
    v_perm_b32 v61, v55, v54, s31
    v_or_b32 v60, v60, v61
    v_xor_b32 v62, s66, v60
    v_cmp_ne_u32 vcc, 0, v62
    s_cbranch_vccz L_hok
    s_sleep 8
    s_add_u32 s68, s68, 1
    s_cmp_gt_u32 s68, 200000
    s_cbranch_scc0 L_hpoll
L_hok:
    s_movk_i32 s68, 0x80
    v_mov_b32 v15, 0xff
    v_bfi_b32 v52, v15, s68, v52
    v_bfi_b32 v53, v15, s68, v53
    v_bfi_b32 v54, v15, s68, v54
    v_bfi_b32 v55, v15, s68, v55
    s_nop 0
    v_permlane16_swap_b32 v52, v54
    v_permlane16_swap_b32 v53, v55
    v_add_f32 v52, v52, v54
    v_add_f32 v53, v53, v55
    s_nop 0
    v_add_f32_dpp v52, v52, v52 quad_perm:[1,0,3,2] row_mask:0xf bank_mask:0xf
    v_add_f32_dpp v53, v53, v53 quad_perm:[1,0,3,2] row_mask:0xf bank_mask:0xf
    s_nop 0
    v_add_f32_dpp v52, v52, v52 quad_perm:[2,3,0,1] row_mask:0xf bank_mask:0xf
    v_add_f32_dpp v53, v53, v53 quad_perm:[2,3,0,1] row_mask:0xf bank_mask:0xf
    s_nop 0
    v_add_f32_dpp v52, v52, v52 row_half_mirror row_mask:0xf bank_mask:0xf
    v_add_f32_dpp v53, v53, v53 row_half_mirror row_mask:0xf bank_mask:0xf
    s_nop 0
    v_add_f32_dpp v52, v52, v52 row_mirror row_mask:0xf bank_mask:0xf
    v_add_f32_dpp v53, v53, v53 row_mirror row_mask:0xf bank_mask:0xf
    v_cvt_pk_bf16_f32 v60, v52, v53
    v_lshlrev_b32 v52, 16, v60
    v_and_b32 v53, 0xffff0000, v60
    v_lshlrev_b32 v60, 16, v44
    v_and_b32 v61, 0xffff0000, v44
    v_add_f32 v52, v52, v60
    v_add_f32 v53, v53, v61
    v_cvt_pk_bf16_f32 v60, v52, v53
    v_lshlrev_b32 v52, 16, v60
    v_and_b32 v53, 0xffff0000, v60
    v_mul_f32 v60, v52, v52
    v_mul_f32 v60, 0x3d372713, v60
    v_fma_f32 v60, v60, v52, v52
    v_mul_f32 v60, 0xc0135761, v60
    v_exp_f32 v60, v60
    s_nop 0
    v_add_f32 v60, 1.0, v60
    v_rcp_f32 v60, v60
    s_nop 0
    v_mul_f32 v52, v52, v60
    v_cvt_pk_bf16_f32 v52, v52, v52
    v_mul_f32 v61, v53, v53
    v_mul_f32 v61, 0x3d372713, v61
    v_fma_f32 v61, v61, v53, v53
    v_mul_f32 v61, 0xc0135761, v61
    v_exp_f32 v61, v61
    s_nop 0
    v_add_f32 v61, 1.0, v61
    v_rcp_f32 v61, v61
    s_nop 0
    v_mul_f32 v53, v53, v61
    v_cvt_pk_bf16_f32 v53, v53, v53
    ds_write_b64 v13, v[52:53] offset:1152
    s_lshl_b32 s68, s3, 2
    v_mov_b32 v5, s68
    ds_write_b32 v5, v6 offset:784
    s_waitcnt lgkmcnt(0)
    s_cmp_eq_u32 s3, 3
    s_cbranch_scc0 L_fin
    v_and_b32 v9, 8, v1
    v_lshl_add_u32 v7, v3, 4, v9
    s_lshl_b32 s68, s28, 10
    s_add_u32 s68, s68, 524288
    v_lshl_add_u32 v8, v1, 4, s68
    s_and_b32 s24, s29, 1
    s_lshl_b32 s69, s24, 9
    s_add_u32 s68, s68, s69
    s_and_b32 s69, s2, 0xf0
    s_add_u32 s68, s68, s69
    v_lshl_add_u32 v5, v9, 5, s68
    s_lshl_b32 s24, s24, 5
    s_add_u32 s25, s24, 16
    v_and_b32 v10, 15, v1
    v_lshlrev_b32 v10, 2, v10
    s_mov_b32 s68, 0
L_lml:
    ds_read_b128 v[48:51], v6 offset:784
    ds_read_b64 v[54:55], v7 offset:832
    s_waitcnt lgkmcnt(0)
    v_min3_f32 v48, v48, v49, v50
    v_min_f32 v48, v48, v55
    v_cmp_gt_f32 vcc, 0, v48
    s_cbranch_vccz L_lmlok
    s_sleep 2
    s_add_u32 s68, s68, 1
    s_cmp_gt_u32 s68, 200000
    s_cbranch_scc0 L_lml
L_lmlok:
    v_mov_b32 v56, v54
    s_nop 1
    v_max_f32_dpp v56, v56, v56 quad_perm:[1,0,3,2] row_mask:0xf bank_mask:0xf
    s_nop 1
    v_max_f32_dpp v56, v56, v56 quad_perm:[2,3,0,1] row_mask:0xf bank_mask:0xf
    s_nop 1
    v_max_f32_dpp v56, v56, v56 row_half_mirror row_mask:0xf bank_mask:0xf
    v_sub_f32 v57, v54, v56
    v_exp_f32 v57, v57
    s_nop 0
    v_mul_f32 v57, v57, v55
    s_nop 1
    v_add_f32_dpp v57, v57, v57 quad_perm:[1,0,3,2] row_mask:0xf bank_mask:0xf
    s_nop 1
    v_add_f32_dpp v57, v57, v57 quad_perm:[2,3,0,1] row_mask:0xf bank_mask:0xf
    s_nop 1
    v_add_f32_dpp v57, v57, v57 row_half_mirror row_mask:0xf bank_mask:0xf
    v_mov_b32 v59, s66
    s_mov_b64 exec, 0x101
    s_cmp_eq_u32 s100, 0
    s_cbranch_scc0 L_sf3
    buffer_store_dwordx4 v[56:59], v5, s[20:23], 0 offen
L_sd3:
    s_mov_b32 s68, 0
    s_mov_b64 exec, -1
L_mlpoll:
    buffer_load_dwordx4 v[60:63], v8, s[20:23], 0 offen sc1 nt
    s_waitcnt vmcnt(0)
    v_cmp_ne_u32 vcc, s66, v63
    s_cbranch_vccz L_mlok
    s_add_u32 s68, s68, 1
    s_cmp_gt_u32 s68, 200000
    s_cbranch_scc0 L_mlpoll
L_mlok:
    v_mov_b32 v62, v60
    s_nop 1
    v_max_f32_dpp v62, v62, v62 quad_perm:[1,0,3,2] row_mask:0xf bank_mask:0xf
    s_nop 1
    v_max_f32_dpp v62, v62, v62 quad_perm:[2,3,0,1] row_mask:0xf bank_mask:0xf
    s_nop 1
    v_max_f32_dpp v62, v62, v62 row_half_mirror row_mask:0xf bank_mask:0xf
    s_nop 1
    v_max_f32_dpp v62, v62, v62 row_mirror row_mask:0xf bank_mask:0xf
    v_sub_f32 v60, v60, v62
    v_exp_f32 v60, v60
    s_nop 0
    v_mul_f32 v61, v60, v61
    s_nop 1
    v_add_f32_dpp v61, v61, v61 quad_perm:[1,0,3,2] row_mask:0xf bank_mask:0xf
    s_nop 1
    v_add_f32_dpp v61, v61, v61 quad_perm:[2,3,0,1] row_mask:0xf bank_mask:0xf
    s_nop 1
    v_add_f32_dpp v61, v61, v61 row_half_mirror row_mask:0xf bank_mask:0xf
    s_nop 1
    v_add_f32_dpp v61, v61, v61 row_mirror row_mask:0xf bank_mask:0xf
    v_rcp_f32 v61, v61
    v_cmp_ne_u32 vcc, 0, v9
    v_readlane_b32 s4, v62, s24
    v_readlane_b32 s5, v62, s25
    v_readlane_b32 s6, v61, s24
    v_readlane_b32 s7, v61, s25
    v_mov_b32 v56, s4
    v_mov_b32 v57, s5
    v_cndmask_b32 v56, v56, v57, vcc
    v_mov_b32 v58, s6
    v_mov_b32 v57, s7
    v_cndmask_b32 v58, v58, v57, vcc
    v_sub_f32 v54, v54, v56
    v_exp_f32 v54, v54
    s_nop 0
    v_mul_f32 v54, v54, v58
    v_mul_f32 v54, v54, v46
    ds_write_b32 v10, v54 offset:1024
    s_waitcnt lgkmcnt(0)
L_fin:
L_end:
    s_endpgm
L_sf3:
    buffer_store_dwordx4 v[56:59], v5, s[20:23], 0 offen sc1
    s_branch L_sd3
.section .rodata,"a"
.p2align 6
.amdhsa_kernel gated_mix__sliding_block_cached__dense_activation_gelu__decode_kernel
  .amdhsa_next_free_vgpr 168
  .amdhsa_next_free_sgpr 102
  .amdhsa_accum_offset 168
  .amdhsa_group_segment_fixed_size 0
  .amdhsa_kernarg_size 112
  .amdhsa_user_sgpr_count 2
  .amdhsa_user_sgpr_kernarg_segment_ptr 1
  .amdhsa_system_sgpr_workgroup_id_x 1
.end_amdhsa_kernel
```
